```python
import torch

def _softmax(x, axis=-1):
    return torch.softmax(x, dim=axis)
def _gelu(x):
    return torch.nn.functional.gelu(x, approximate="tanh")
def _silu(x):
    return torch.nn.functional.silu(x)
def _sigmoid(x):
    return torch.sigmoid(x)
def _layernorm(x, axis=-1, eps=1e-5):
    m = x.mean(dim=axis, keepdim=True)
    v = x.var(dim=axis, keepdim=True, unbiased=False)
    return (x - m) / torch.sqrt(v + eps)
def _scatter_add(tgt, idx, src, axis=0):
    return tgt.clone().index_add_(axis, idx, src)
def _segment_sum(src, seg, n):
    out = torch.zeros((n,) + src.shape[1:], dtype=src.dtype)
    return out.index_add_(0, seg, src)
def _pad(x, pw):
    flat = tuple(v for pair in reversed(pw) for v in pair)
    return torch.nn.functional.pad(x, flat)

kernel_name = 'standalone__moe_arch_mod__decode'

def setup_inputs():

    _w = (lambda a: (lambda t: t.to(torch.bfloat16) if t.is_floating_point() else t)(torch.as_tensor(a)))
    B, S, D, F, C = 8, 1, 1024, 3584, 1
    return {
        "x": _w((lambda *s: torch.randn(*s, dtype=torch.bfloat16) * 0.2)(B, S, D)),
        "w_r": _w((lambda *s: torch.randn(*s, dtype=torch.bfloat16) * 0.2)(D)),
        "w_gate": _w((lambda *s: torch.randn(*s, dtype=torch.bfloat16) * 0.1)(D, F)),
        "w_up": _w((lambda *s: torch.randn(*s, dtype=torch.bfloat16) * 0.1)(D, F)),
        "w_down": _w((lambda *s: torch.randn(*s, dtype=torch.bfloat16) * 0.1)(F, D)),
    }

def reference(x, w_r, w_gate, w_up, w_down):
    B, S, D = x.shape
    C = 1
    r = x @ w_r
    idx = torch.argsort(-r, axis=-1)[:, :C]
    idx_e = (lambda x, n, axis: torch.repeat_interleave(x, n, dim=axis))(idx.reshape(B, C, 1), D, axis=2)
    x_sel = (lambda x, i, axis: torch.take_along_dim(x, i, dim=axis))(x, idx_e, axis=1)
    g = _silu(x_sel @ w_gate)
    u = x_sel @ w_up
    y = (g * u) @ w_down
    r_sel = _sigmoid((lambda x, i, axis: torch.take_along_dim(x, i, dim=axis))(r, idx, axis=1))
    y = y * r_sel.reshape(B, C, 1)
    b_off = (torch.arange(B) * S).reshape(B, 1)
    flat_idx = (idx + b_off).reshape(B * C)
    zero = (x * 0.0).reshape(B * S, D)
    upd = _scatter_add(zero, flat_idx, y.reshape(B * C, D), axis=0)
    return x + upd.reshape(B, S, D)
```

```asm
; @launch grid=(256,1,1) block=(512,1,1) lds=110592
.amdgcn_target "amdgcn-amd-amdhsa--gfx950"
.text
.globl standalone__moe_arch_mod__decode_kernel
.p2align 8
.type standalone__moe_arch_mod__decode_kernel,@function
standalone__moe_arch_mod__decode_kernel:
    s_load_dwordx16 s[4:19], s[0:1], 0
    s_cmp_ge_u32 s2, 256
    s_cbranch_scc1 L_end
    v_lshrrev_b32 v2, 6, v0
    v_and_b32 v1, 63, v0
    v_readfirstlane_b32 s3, v2
    s_getpc_b64 s[66:67]
L_pc:
    v_lshlrev_b32 v54, 7, v1
    s_cmp_lg_u32 s3, 7
    s_cbranch_scc1 L_nopf
    v_min_u32 v54, L_end-L_pc, v54
    global_load_dword v60, v54, s[66:67]
L_nopf:
    s_and_b32 s56, s2, 7
    s_bfe_u32 s57, s2, 0x20003
    s_bfe_u32 s58, s2, 0x20005
    s_lshr_b32 s59, s2, 7
    s_add_u32 s63, s56, 3
    s_and_b32 s63, s63, 7
    s_cmp_eq_u32 s63, 7
    s_cselect_b32 s63, 3, s63
    s_mul_i32 s61, s56, 7
    s_bfe_u32 s62, s2, 0x30004
    s_cmp_ge_u32 s62, s63
    s_addc_u32 s62, s62, 0
    s_and_b32 s65, s57, 1
    s_lshl_b32 s65, s65, 1
    s_cmp_eq_u32 s58, 3
    s_cselect_b32 s62, s63, s62
    s_cselect_b32 s65, s57, s65
    s_cselect_b32 s64, 4, 8
    s_cselect_b32 s74, 16, 0
    s_add_u32 s62, s62, s61
    v_lshrrev_b32 v17, 3, v1
    v_and_b32 v17, 6, v17
    v_xor_b32 v17, v17, v1
    v_and_b32 v17, 7, v17
    v_lshlrev_b32 v17, 4, v17
    v_bfe_u32 v16, v1, 3, 2
    v_lshrrev_b32 v9, 5, v1
    v_lshl_add_u32 v16, v9, 3, v16
    v_mul_u32_u24 v4, 7168, v16
    v_add_u32 v4, v4, v17
    s_lshr_b32 s66, s3, 2
    s_mul_i32 s67, s66, s64
    s_lshl3_add_u32 s67, s65, s67
    s_lshl_b32 s67, s67, 3
    s_and_b32 s68, s3, 1
    s_lshl2_add_u32 s67, s68, s67
    s_bfe_u32 s68, s3, 0x10001
    s_add_u32 s67, s67, s68
    s_mul_i32 s67, s67, 28672
    s_lshl_b32 s68, s62, 7
    s_add_u32 s92, s67, s68
    s_and_b32 s68, s3, 3
    s_lshl_b32 s66, s66, 5
    s_add_u32 s66, s66, s68
    s_add_u32 s66, s66, s74
    s_lshl_b32 s66, s66, 10
    s_add_u32 s90, s66, 32768
    s_mov_b32 s93, 229376
    s_mov_b32 s22, 7340032
    s_mov_b32 s23, 0x20000
    s_cmp_ge_u32 s3, 4
    s_cbranch_scc1 L_addr
    s_cmp_eq_u32 s59, 0
    s_mov_b32 m0, s90
    s_waitcnt lgkmcnt(0)
L_issue:
    s_cselect_b64 s[20:21], s[8:9], s[10:11]
    s_cmp_eq_u32 s58, 3
    s_cbranch_scc1 L_short
    buffer_load_dwordx4 v4, s[20:23], s92 offen nt lds
    s_addk_i32 m0, 0x1000
    s_add_u32 s92, s92, s93
    buffer_load_dwordx4 v4, s[20:23], s92 offen nt lds
    s_addk_i32 m0, 0x1000
    s_add_u32 s92, s92, s93
    buffer_load_dwordx4 v4, s[20:23], s92 offen nt lds
    s_addk_i32 m0, 0x1000
    s_add_u32 s92, s92, s93
    buffer_load_dwordx4 v4, s[20:23], s92 offen nt lds
    s_addk_i32 m0, 0x1000
    s_add_u32 s92, s92, s93
L_short:
    buffer_load_dwordx4 v4, s[20:23], s92 offen nt lds
    s_addk_i32 m0, 0x1000
    s_add_u32 s92, s92, s93
    buffer_load_dwordx4 v4, s[20:23], s92 offen nt lds
    s_addk_i32 m0, 0x1000
    s_add_u32 s92, s92, s93
    buffer_load_dwordx4 v4, s[20:23], s92 offen nt lds
    s_addk_i32 m0, 0x1000
    s_add_u32 s92, s92, s93
    buffer_load_dwordx4 v4, s[20:23], s92 offen nt lds
    s_cmp_ge_u32 s3, 4
    s_cbranch_scc1 L_tags
L_addr:
    v_lshl_add_u32 v8, v16, 11, v17
    v_and_b32 v18, 7, v1
    v_lshlrev_b32 v18, 4, v18
    v_bfe_u32 v10, v1, 3, 1
    v_lshl_add_u32 v10, v10, 11, v18
    v_bfe_u32 v11, v1, 4, 1
    v_lshl_add_u32 v10, v11, 7, v10
    v_lshlrev_b32 v12, 4, v1
    s_mov_b64 s[26:27], s[22:23]
    s_mov_b32 s30, 4194304
    s_mov_b32 s31, s23
    s_movk_i32 s34, 16384
    s_mov_b32 s35, s23
    s_mov_b64 s[38:39], s[34:35]
    s_movk_i32 s42, 2048
    s_mov_b32 s43, s23
    s_lshl2_add_u32 s60, s59, s57
    s_lshl2_add_u32 s69, s62, s68
    s_lshr_b32 s52, s57, 1
    s_cmp_eq_u32 s58, 3
    s_cselect_b32 s52, s52, 0
    s_lshl2_add_u32 s69, s69, s52
    s_lshl1_add_u32 s69, s69, s59
    s_and_b32 s52, s57, 1
    s_lshl1_add_u32 s69, s69, s52
    s_lshl_b32 s69, s69, 8
    s_add_u32 s69, s69, 262144
    s_lshl_b32 s96, s56, 10
    s_add_u32 s96, s96, 4096
    s_bfe_u32 s53, s2, 0x30003
    s_lshl3_add_u32 s53, s59, s53
    s_mul_i32 s55, s53, 7
    s_add_u32 s55, s55, s3
    s_lshl_b32 s70, s55, 16
    s_and_b32 s52, s2, 7
    s_cmp_eq_u32 s52, 0
    s_cselect_b32 s101, 5, s52
    s_cmp_eq_u32 s52, 5
    s_cselect_b32 s101, 0, s101
    s_cmp_lt_u32 s58, 2
    s_addc_u32 s54, s101, s101
    s_lshl_b32 s72, s62, 7
    s_add_u32 s98, s72, 32768
    s_cmp_ge_u32 s3, 4
    s_cbranch_scc0 L_rest
    s_lshl_b32 s74, s74, 4
    s_lshl_b32 s64, s74, 15
    s_lshl_b32 s65, s65, 9
    s_lshl_b32 s72, s68, 12
    s_add_u32 s65, s65, s72
    s_lshr_b32 s72, s72, 1
    s_add_u32 m0, s72, 98304
    s_lshl_b32 s72, s68, 3
    v_xor_b32 v6, s72, v1
    v_add_u32 v2, 1, v9
    v_mul_u32_u24 v2, s74, v2
    v_bfe_u32 v7, v6, 4, 1
    v_xor_b32 v7, 1, v7
    v_mul_u32_u24 v7, s64, v7
    v_sub_u32 v2, v7, v2
    v_lshl_add_u32 v13, v6, 4, v2
    v_xor_b32 v6, 4, v6
    v_lshl_add_u32 v14, v6, 4, v2
    s_add_u32 s74, s65, 1024
    s_waitcnt lgkmcnt(0)
    s_mov_b64 s[32:33], s[4:5]
    s_mov_b64 s[28:29], s[18:19]
    s_mov_b64 s[40:41], s[6:7]
    buffer_load_dwordx4 v13, s[32:35], s65 offen lds
    buffer_load_dwordx4 v14, s[32:35], s74 offen offset:1024 lds
    buffer_load_dword v61, v10, s[28:31], s69 offen sc1
    s_lshl2_add_u32 s52, s3, s58
    s_cmp_lg_u32 s52, 31
    s_cbranch_scc1 L_rest
    s_lshl_b32 s72, s60, 11
    s_lshl_b32 s62, s60, 7
    s_add_u32 s62, s62, s96
    buffer_load_dwordx4 v[64:67], v12, s[32:35], s72 offen
    buffer_load_dwordx4 v[68:71], v12, s[32:35], s72 offen offset:1024
    buffer_load_dwordx4 v[72:75], v12, s[40:43], 0 offen
    buffer_load_dwordx4 v[76:79], v12, s[40:43], 0 offen offset:1024
    buffer_load_dword v62, v18, s[28:31], s62 offen sc1
    s_add_u32 s72, s61, s60
    s_lshl_b32 s72, s72, 7
    s_add_u32 s72, s72, 32768
    buffer_load_dword v63, v18, s[28:31], s72 offen sc1
L_rest:
    s_load_dwordx4 s[44:47], s[18:19], 0
    s_mov_b64 s[24:25], s[12:13]
    s_mov_b64 s[32:33], s[4:5]
    s_mov_b64 s[28:29], s[18:19]
    s_mov_b64 s[36:37], s[14:15]
    s_lshl_b32 s52, s54, 7
    s_add_u32 s70, s70, s52
    s_and_b32 s100, s54, 7
    s_cmp_eq_u32 s100, 3
    s_cselect_b32 s100, 7, 7
    s_cmp_eq_u32 s58, 3
    s_cselect_b32 s100, 6, s100
    s_cmp_eq_u32 s56, 4
    s_cselect_b32 s100, 7, s100
    s_mov_b32 s75, 0
    s_mov_b32 s73, 0x07060302
    v_mov_b32 v15, 255
    v_lshrrev_b32 v19, 4, v1
    v_bfe_u32 v9, v1, 3, 2
    v_xor_b32 v9, s3, v9
    v_and_b32 v9, 3, v9
    v_lshlrev_b32 v9, 5, v9
    v_lshrrev_b32 v6, 2, v1
    v_lshl_add_u32 v9, v6, 7, v9
    v_and_b32 v7, 3, v1
    v_lshl_add_u32 v9, v7, 3, v9
    v_add_u32 v6, 32768, v9
    v_bfe_u32 v54, v1, 2, 1
    v_lshl_add_u32 v14, v7, 1, v54
    v_lshlrev_b32 v14, 4, v14
    v_lshl_add_u32 v14, v19, 7, v14
    v_add_u32 v14, 106496, v14
    v_and_b32 v7, 7, v1
    v_mul_u32_u24 v7, 1088, v7
    v_lshl_add_u32 v7, v19, 4, v7
    v_add_u32 v7, 98304, v7
    v_lshlrev_b32 v13, 3, v0
    v_add_u32 v13, 106496, v13
    s_lshl_b32 s71, s55, 10
    s_add_u32 s71, s71, 65536
    s_and_b32 s64, s58, 2
    s_lshl_b32 s64, s64, 2
    v_lshrrev_b32 v11, 3, v1
    v_add_u32 v11, s64, v11
    v_lshrrev_b32 v26, 1, v11
    v_cmp_le_u32 vcc, s63, v26
    v_and_b32 v27, 1, v26
    v_lshlrev_b32 v27, 10, v27
    v_addc_co_u32 v26, vcc, 0, v26, vcc
    v_lshlrev_b32 v26, 14, v26
    s_lshl_b32 s64, s63, 14
    v_add_u32 v27, s64, v27
    v_cmp_lt_u32 vcc, 11, v11
    v_and_b32 v11, 1, v11
    v_lshl_add_u32 v11, v11, 8, v18
    v_cndmask_b32 v26, v26, v27, vcc
    v_add_u32 v11, v11, v26
    s_lshr_b32 s72, s53, 2
    s_lshl2_add_u32 s72, s61, s72
    s_and_b32 s64, s53, 1
    s_lshl1_add_u32 s72, s72, s64
    s_lshl_b32 s72, s72, 4
    s_bfe_u32 s64, s53, 0x10001
    s_add_u32 s72, s72, s64
    s_lshl_b32 s72, s72, 7
    s_add_u32 s72, s72, 262144
    s_bfe_u32 s99, s53, 0x10001
    s_lshl_b32 s99, s99, 2
    v_add_u32 v20, s99, v19
    v_lshlrev_b32 v21, 7, v20
    s_lshr_b32 s97, s53, 2
    s_lshl2_add_u32 s97, s54, s97
    s_and_b32 s99, s53, 1
    s_lshl1_add_u32 s97, s97, s99
    s_lshl_b32 s97, s97, 4
    v_lshrrev_b32 v22, 3, v18
    v_lshl_add_u32 v22, v20, 11, v22
    s_mul_i32 s99, s3, 24*2048
    s_add_u32 s99, s99, s70
    s_sub_u32 s99, s99, 1835008
    s_andn2_b32 s64, s53, 4
    s_lshl2_add_u32 s64, s64, s58
    s_add_u32 s64, s64, 2
    s_mul_i32 s64, s64, 56*2048
    s_lshl_b32 s68, s101, 8
    s_add_u32 s64, s64, s68
    s_cmp_lt_u32 s58, 2
    s_cselect_b32 s99, s64, s99
    s_cselect_b32 s91, s3, 0
    v_lshlrev_b32 v25, 11, v1
    s_add_u32 s67, s61, s60
    s_lshl3_add_u32 s67, s67, s3
    s_lshl_b32 s65, s67, 4
    s_add_u32 s65, s65, 32768
    s_lshl_b32 s66, s67, 11
    s_add_u32 s66, s66, 262144
    s_lshl_b32 s67, s67, 8
    s_add_u32 s67, s67, 65536
    v_lshlrev_b32 v56, 2, v1
    s_getreg_b32 s94, hwreg(HW_REG_XCC_ID, 0, 3)
    s_mov_b32 s95, 0
    s_cmp_ge_u32 s3, 4
    s_cbranch_scc0 L_tags
    s_cmp_eq_u32 s59, 0
    s_mov_b32 m0, s90
    s_branch L_issue
L_tags:
    s_waitcnt lgkmcnt(0)
    s_add_u32 s44, s44, 693
    s_add_u32 s45, s45, 319
    s_add_u32 s46, s46, 977
    s_add_u32 s47, s47, 136
    s_and_b32 s48, s44, 255
    s_and_b32 s49, s45, 255
    s_and_b32 s50, s46, 255
    s_and_b32 s51, s47, 255
    s_add_u32 s4, s44, 693
    s_add_u32 s5, s45, 319
    s_add_u32 s6, s46, 977
    s_add_u32 s7, s47, 136
    s_and_b32 s8, s4, 255
    s_and_b32 s9, s5, 255
    s_and_b32 s10, s6, 255
    s_and_b32 s11, s7, 255
    s_xor_b32 s94, s94, s11
    v_and_b32 v54, 3, v1
    v_mov_b32 v55, s44
    v_mov_b32 v57, s45
    v_cmp_eq_u32 vcc, 1, v54
    s_nop 1
    v_cndmask_b32 v55, v55, v57, vcc
    v_mov_b32 v57, s46
    v_cmp_eq_u32 vcc, 2, v54
    s_nop 1
    v_cndmask_b32 v55, v55, v57, vcc
    v_mov_b32 v57, s47
    v_cmp_eq_u32 vcc, 3, v54
    s_nop 1
    v_cndmask_b32 v55, v55, v57, vcc
    v_mov_b32 v58, v55
    v_and_b32 v55, 0xffff, v55
    v_mov_b32 v40, 0
    v_mov_b32 v41, 0
    v_mov_b32 v42, 0
    v_mov_b32 v43, 0
    s_cmp_ge_u32 s3, 4
    s_cbranch_scc0 L_comp
    s_lshl2_add_u32 s52, s3, s58
    s_cmp_eq_u32 s52, 31
    s_cbranch_scc1 L_router
    s_waitcnt vmcnt(8)
    s_cmp_lg_u32 s58, 3
    s_cbranch_scc1 L_s0
    s_waitcnt vmcnt(4)
L_s0:
    s_barrier
    s_waitcnt vmcnt(3)
    s_cmp_lt_u32 s3, s100
    s_cbranch_scc1 L_s1
    s_cmp_eq_u32 s3, 7
    s_cbranch_scc1 L_s1
    s_lshl_b32 m0, s3, 12
    s_add_u32 s68, s70, 0
    buffer_load_dwordx4 v8, s[24:27], s68 offen offset:0 nt lds
    s_add_u32 s68, s70, 31744
    buffer_load_dwordx4 v8, s[24:27], s68 offen offset:1024 nt lds
    s_add_u32 s68, s70, 6144
    buffer_load_dwordx4 v8, s[24:27], s68 offen offset:2048 nt lds
    s_add_u32 s68, s70, 37888
    buffer_load_dwordx4 v8, s[24:27], s68 offen offset:3072 nt lds
L_s0x:
    s_barrier
    s_waitcnt vmcnt(5)
    s_barrier
    s_waitcnt vmcnt(4)
    s_barrier
    s_branch L_pub
L_s1:
    s_barrier
    s_waitcnt vmcnt(1)
    s_barrier
    s_waitcnt vmcnt(0)
    s_barrier
    s_branch L_pub
L_comp:
    s_waitcnt vmcnt(0)
    s_cmp_eq_u32 s58, 3
    s_barrier
    v_xor_b32 v18, 256, v7
    ds_read_b128 v[80:83], v18
    v_xor_b32 v18, 320, v7
    ds_read_b128 v[84:87], v18
    v_xor_b32 v18, 384, v7
    ds_read_b128 v[88:91], v18
    v_xor_b32 v18, 448, v7
    ds_read_b128 v[92:95], v18
    v_xor_b32 v18, 768, v7
    ds_read_b128 v[112:115], v18
    v_xor_b32 v18, 832, v7
    ds_read_b128 v[116:119], v18
    v_xor_b32 v18, 896, v7
    ds_read_b128 v[120:123], v18
    v_xor_b32 v18, 960, v7
    ds_read_b128 v[124:127], v18
    s_cbranch_scc1 L_short0
    s_waitcnt lgkmcnt(4)
    ds_read_b128 v[64:67], v7
    v_xor_b32 v18, 64, v7
    ds_read_b128 v[68:71], v18
    v_xor_b32 v18, 128, v7
    ds_read_b128 v[72:75], v18
    v_xor_b32 v18, 192, v7
    ds_read_b128 v[76:79], v18
    v_xor_b32 v18, 512, v7
    ds_read_b128 v[96:99], v18
    v_xor_b32 v18, 576, v7
    ds_read_b128 v[100:103], v18
    v_xor_b32 v18, 640, v7
    ds_read_b128 v[104:107], v18
    v_xor_b32 v18, 704, v7
    ds_read_b128 v[108:111], v18
    s_waitcnt lgkmcnt(4)
    ds_read_b64_tr_b16 v[128:129], v6 offset:0
    ds_read_b64_tr_b16 v[130:131], v6 offset:2048
    ds_read_b64_tr_b16 v[132:133], v6 offset:4096
    ds_read_b64_tr_b16 v[134:135], v6 offset:6144
    ds_read_b64_tr_b16 v[136:137], v6 offset:8192
    ds_read_b64_tr_b16 v[138:139], v6 offset:10240
    ds_read_b64_tr_b16 v[140:141], v6 offset:12288
    ds_read_b64_tr_b16 v[142:143], v6 offset:14336
    s_waitcnt lgkmcnt(6)
    v_mfma_f32_16x16x32_bf16 v[40:43], v[64:67], v[128:131], v[40:43]
    s_waitcnt lgkmcnt(4)
    v_mfma_f32_16x16x32_bf16 v[40:43], v[68:71], v[132:135], v[40:43]
    s_waitcnt lgkmcnt(2)
    v_mfma_f32_16x16x32_bf16 v[40:43], v[72:75], v[136:139], v[40:43]
    s_waitcnt lgkmcnt(0)
    v_mfma_f32_16x16x32_bf16 v[40:43], v[76:79], v[140:143], v[40:43]
L_short0:
    s_waitcnt lgkmcnt(4)
    ds_read_b64_tr_b16 v[128:129], v6 offset:16384
    ds_read_b64_tr_b16 v[130:131], v6 offset:18432
    ds_read_b64_tr_b16 v[132:133], v6 offset:20480
    ds_read_b64_tr_b16 v[134:135], v6 offset:22528
    ds_read_b64_tr_b16 v[136:137], v6 offset:24576
    ds_read_b64_tr_b16 v[138:139], v6 offset:26624
    ds_read_b64_tr_b16 v[140:141], v6 offset:28672
    ds_read_b64_tr_b16 v[142:143], v6 offset:30720
    s_waitcnt lgkmcnt(6)
    v_mfma_f32_16x16x32_bf16 v[40:43], v[80:83], v[128:131], v[40:43]
    s_waitcnt lgkmcnt(4)
    v_mfma_f32_16x16x32_bf16 v[40:43], v[84:87], v[132:135], v[40:43]
    s_waitcnt lgkmcnt(2)
    v_mfma_f32_16x16x32_bf16 v[40:43], v[88:91], v[136:139], v[40:43]
    s_waitcnt lgkmcnt(0)
    v_mfma_f32_16x16x32_bf16 v[40:43], v[92:95], v[140:143], v[40:43]
    s_barrier
    s_cbranch_scc1 L_short1
    ds_read_b64_tr_b16 v[128:129], v6 offset:32768
    ds_read_b64_tr_b16 v[130:131], v6 offset:34816
    ds_read_b64_tr_b16 v[132:133], v6 offset:36864
    ds_read_b64_tr_b16 v[134:135], v6 offset:38912
    ds_read_b64_tr_b16 v[136:137], v6 offset:40960
    ds_read_b64_tr_b16 v[138:139], v6 offset:43008
    ds_read_b64_tr_b16 v[140:141], v6 offset:45056
    ds_read_b64_tr_b16 v[142:143], v6 offset:47104
L_short1:
    ds_read_b64_tr_b16 v[144:145], v6 offset:49152
    ds_read_b64_tr_b16 v[146:147], v6 offset:51200
    s_cbranch_scc1 L_short2
    s_waitcnt lgkmcnt(8)
    v_mfma_f32_16x16x32_bf16 v[40:43], v[96:99], v[128:131], v[40:43]
    s_waitcnt lgkmcnt(6)
    v_mfma_f32_16x16x32_bf16 v[40:43], v[100:103], v[132:135], v[40:43]
    s_waitcnt lgkmcnt(4)
    v_mfma_f32_16x16x32_bf16 v[40:43], v[104:107], v[136:139], v[40:43]
    s_waitcnt lgkmcnt(2)
    v_mfma_f32_16x16x32_bf16 v[40:43], v[108:111], v[140:143], v[40:43]
L_short2:
    s_barrier
    ds_read_b64_tr_b16 v[148:149], v6 offset:53248
    ds_read_b64_tr_b16 v[150:151], v6 offset:55296
    ds_read_b64_tr_b16 v[152:153], v6 offset:57344
    ds_read_b64_tr_b16 v[154:155], v6 offset:59392
    s_waitcnt lgkmcnt(4)
    v_mfma_f32_16x16x32_bf16 v[40:43], v[112:115], v[144:147], v[40:43]
    s_barrier
    ds_read_b64_tr_b16 v[156:157], v6 offset:61440
    ds_read_b64_tr_b16 v[158:159], v6 offset:63488
    s_waitcnt lgkmcnt(2)
    v_mfma_f32_16x16x32_bf16 v[40:43], v[116:119], v[148:151], v[40:43]
    v_mfma_f32_16x16x32_bf16 v[40:43], v[120:123], v[152:155], v[40:43]
    s_waitcnt lgkmcnt(0)
    v_mfma_f32_16x16x32_bf16 v[40:43], v[124:127], v[156:159], v[40:43]
    s_mov_b32 exec_hi, 0
    s_nop 6
    v_add_u32 v40, 128, v40
    v_add_u32 v41, 128, v41
    v_add_u32 v42, 128, v42
    v_add_u32 v43, 128, v43
    v_bfi_b32 v40, v15, s44, v40
    v_bfi_b32 v41, v15, s45, v41
    v_bfi_b32 v42, v15, s46, v42
    v_bfi_b32 v43, v15, s47, v43
    buffer_store_dwordx4 v[40:43], v10, s[28:31], s69 offen
    s_mov_b32 exec_hi, -1
L_pub:
    s_barrier
    s_cmp_lt_u32 s58, 2
    s_cbranch_scc1 L_defer
    s_cmp_eq_u32 s60, 7
    s_cbranch_scc1 L_defer
    s_cmp_eq_u32 s58, 2
    s_cbranch_scc1 L_red
    s_cmp_lt_u32 s3, 5
    s_cbranch_scc1 L_defer
    s_mov_b32 s91, 6
    s_sub_u32 s99, s99, 573440
    s_branch L_defer
L_red:
    s_cmp_eq_u32 s60, s63
    s_cbranch_scc1 L_r4_poll
    buffer_load_dwordx4 v[64:67], v12, s[28:31], s66 offen sc1
    s_mov_b32 s52, 12
L_r2:
    buffer_load_dwordx4 v[68:71], v12, s[28:31], s66 offen sc1
    s_waitcnt vmcnt(1)
    v_xor_b32 v44, s48, v64
    v_xor_b32 v45, s49, v65
    v_xor_b32 v46, s50, v66
    v_xor_b32 v47, s51, v67
    v_or3_b32 v52, v44, v45, v46
    v_or_b32 v52, v52, v47
    v_and_b32 v52, v52, v15
    v_cmp_ne_u32 vcc, 0, v52
    s_cbranch_vccz L_r_ok
    buffer_load_dwordx4 v[64:67], v12, s[28:31], s66 offen sc1
    s_waitcnt vmcnt(1)
    v_xor_b32 v44, s48, v68
    v_xor_b32 v45, s49, v69
    v_xor_b32 v46, s50, v70
    v_xor_b32 v47, s51, v71
    v_or3_b32 v52, v44, v45, v46
    v_or_b32 v52, v52, v47
    v_and_b32 v52, v52, v15
    v_cmp_ne_u32 vcc, 0, v52
    s_cbranch_vccz L_r_ok
    s_sub_u32 s52, s52, 1
    s_cbranch_scc0 L_r2
L_r_poll:
    buffer_load_dwordx4 v[44:47], v12, s[28:31], s66 offen sc1
    s_waitcnt vmcnt(0)
    v_xor_b32 v44, s48, v44
    v_xor_b32 v45, s49, v45
    v_xor_b32 v46, s50, v46
    v_xor_b32 v47, s51, v47
    v_or3_b32 v52, v44, v45, v46
    v_or_b32 v52, v52, v47
    v_and_b32 v52, v52, v15
    v_cmp_ne_u32 vcc, 0, v52
    s_cbranch_vccz L_r_ok
    s_add_u32 s75, s75, 1
    s_and_b32 s74, s75, 31
    s_cbranch_scc1 L_r_poll
    buffer_wbl2 sc1
    s_cmp_lt_u32 s75, 4194304
    s_cbranch_scc1 L_r_poll
    s_endpgm
L_r4_poll:
    buffer_load_dwordx4 v[44:47], v12, s[28:31], s66 offen sc1
    buffer_load_dwordx4 v[48:51], v12, s[28:31], s66 offen offset:1024 sc1
    s_waitcnt vmcnt(0)
    v_xor_b32 v44, s48, v44
    v_xor_b32 v45, s49, v45
    v_xor_b32 v46, s50, v46
    v_xor_b32 v47, s51, v47
    v_xor_b32 v48, s48, v48
    v_xor_b32 v49, s49, v49
    v_xor_b32 v50, s50, v50
    v_xor_b32 v51, s51, v51
    v_or3_b32 v52, v44, v45, v46
    v_or3_b32 v53, v47, v48, v49
    v_or3_b32 v52, v52, v50, v51
    v_or_b32 v52, v52, v53
    v_and_b32 v52, v52, v15
    v_cmp_ne_u32 vcc, 0, v52
    s_cbranch_vccz L_r4_ok
    s_add_u32 s75, s75, 1
    s_and_b32 s74, s75, 31
    s_cbranch_scc1 L_r4_poll
    buffer_wbl2 sc1
    s_cmp_lt_u32 s75, 4194304
    s_cbranch_scc1 L_r4_poll
    s_endpgm
L_r4_ok:
    v_add_f32 v44, v44, v48
    v_add_f32 v45, v45, v49
    v_add_f32 v46, v46, v50
    v_add_f32 v47, v47, v51
    s_nop 0
L_r_ok:
    v_permlane16_swap_b32 v44, v45
    v_permlane16_swap_b32 v46, v47
    v_add_f32 v44, v44, v45
    v_add_f32 v46, v46, v47
    s_nop 1
    v_permlane32_swap_b32 v44, v46
    v_cvt_pk_bf16_f32 v44, v44, v46
    v_lshlrev_b32 v45, 16, v44
    v_mul_f32 v46, 0xbfb8aa3b, v45
    v_exp_f32 v46, v46
    v_and_b32 v44, 0xffff0000, v44
    v_add_f32 v46, 1.0, v46
    v_rcp_f32 v46, v46
    s_nop 0
    v_mul_f32 v45, v45, v46
    v_cvt_pk_bf16_f32 v45, v45, v45
    v_and_b32 v45, 0xffff0000, v45
    v_mul_f32 v45, v45, v44
    v_cvt_pk_bf16_f32 v45, v45, v45
    v_lshl_or_b32 v45, v45, 16, v55
    buffer_store_dword v45, v56, s[28:31], s67 offen sc1
    s_mov_b64 exec, 15
    buffer_store_dword v58, v56, s[28:31], s65 offen
    s_mov_b64 exec, -1
    s_barrier
L_defer:
    s_cmp_eq_u32 s3, 7
    s_cbranch_scc1 L_final
    s_cmp_ge_u32 s3, s100
    s_cbranch_scc1 L_p2
    s_lshl_b32 m0, s3, 12
    s_add_u32 s68, s70, 0
    buffer_load_dwordx4 v8, s[24:27], s68 offen offset:0 nt lds
    s_add_u32 s68, s70, 31744
    buffer_load_dwordx4 v8, s[24:27], s68 offen offset:1024 nt lds
    s_add_u32 s68, s70, 6144
    buffer_load_dwordx4 v8, s[24:27], s68 offen offset:2048 nt lds
    s_add_u32 s68, s70, 37888
    buffer_load_dwordx4 v8, s[24:27], s68 offen offset:3072 nt lds
L_p2:
    s_cmp_lg_u32 s91, 6
    s_cbranch_scc1 L_p2w
    buffer_load_dword v61, v25, s[24:27], s99 offen
    s_waitcnt vmcnt(1)
    s_branch L_p2b
L_p2w:
    s_waitcnt vmcnt(0)
L_p2b:
    s_barrier
    buffer_load_dwordx4 v[44:47], v12, s[28:31], s71 offen sc1
    s_cmp_ge_u32 s3, 4
    s_cbranch_scc1 L_h_chk
    ds_read_b64_tr_b16 v[128:129], v9 offset:0
    ds_read_b64_tr_b16 v[130:131], v9 offset:2048
    ds_read_b64_tr_b16 v[132:133], v9 offset:4096
    ds_read_b64_tr_b16 v[134:135], v9 offset:6144
    ds_read_b64_tr_b16 v[136:137], v9 offset:8192
    ds_read_b64_tr_b16 v[138:139], v9 offset:10240
    ds_read_b64_tr_b16 v[140:141], v9 offset:12288
    ds_read_b64_tr_b16 v[142:143], v9 offset:14336
    ds_read_b64_tr_b16 v[144:145], v9 offset:16384
    ds_read_b64_tr_b16 v[146:147], v9 offset:18432
    ds_read_b64_tr_b16 v[148:149], v9 offset:20480
    ds_read_b64_tr_b16 v[150:151], v9 offset:22528
    ds_read_b64_tr_b16 v[152:153], v9 offset:24576
    ds_read_b64_tr_b16 v[154:155], v9 offset:26624
    s_branch L_h_chk
L_h_poll:
    buffer_load_dwordx4 v[44:47], v12, s[28:31], s71 offen sc1
L_h_chk:
    s_waitcnt vmcnt(0)
    v_perm_b32 v48, v45, v44, s73
    v_perm_b32 v49, v47, v46, s73
    ds_write_b64 v13, v[48:49]
    v_xor_b32 v32, s44, v44
    v_xor_b32 v33, s45, v45
    v_xor_b32 v34, s46, v46
    v_xor_b32 v35, s47, v47
    v_or3_b32 v32, v32, v33, v34
    v_or_b32 v32, v32, v35
    v_and_b32 v32, 0xffff, v32
    v_cmp_ne_u32 vcc, 0, v32
    s_cbranch_vccz L_h_ok
    s_add_u32 s75, s75, 1
    s_and_b32 s74, s75, 31
    s_cbranch_scc1 L_h_poll
    buffer_wbl2 sc1
    s_cmp_lt_u32 s75, 4194304
    s_cbranch_scc1 L_h_poll
    s_endpgm
L_h_ok:
    s_cmp_ge_u32 s3, 4
    s_waitcnt lgkmcnt(0)
    s_barrier
    s_cbranch_scc1 L_b
    ds_read_b128 v[64:67], v14 offset:0
    ds_read_b128 v[68:71], v14 offset:512
    ds_read_b128 v[72:75], v14 offset:1024
    ds_read_b128 v[76:79], v14 offset:1536
    ds_read_b128 v[80:83], v14 offset:2048
    ds_read_b128 v[84:87], v14 offset:2560
    ds_read_b128 v[88:91], v14 offset:3072
    s_waitcnt lgkmcnt(6)
    v_mfma_f32_16x16x32_bf16 v[40:43], v[64:67], v[128:131], 0
    s_waitcnt lgkmcnt(5)
    v_mfma_f32_16x16x32_bf16 v[40:43], v[68:71], v[132:135], v[40:43]
    s_waitcnt lgkmcnt(4)
    v_mfma_f32_16x16x32_bf16 v[40:43], v[72:75], v[136:139], v[40:43]
    s_waitcnt lgkmcnt(3)
    v_mfma_f32_16x16x32_bf16 v[40:43], v[76:79], v[140:143], v[40:43]
    s_waitcnt lgkmcnt(2)
    v_mfma_f32_16x16x32_bf16 v[40:43], v[80:83], v[144:147], v[40:43]
    s_waitcnt lgkmcnt(1)
    v_mfma_f32_16x16x32_bf16 v[40:43], v[84:87], v[148:151], v[40:43]
    s_waitcnt lgkmcnt(0)
    v_mfma_f32_16x16x32_bf16 v[40:43], v[88:91], v[152:155], v[40:43]
    s_mov_b32 exec_hi, 0
    s_nop 6
    v_add_u32 v40, 128, v40
    v_add_u32 v41, 128, v41
    v_add_u32 v42, 128, v42
    v_add_u32 v43, 128, v43
    v_bfi_b32 v40, v15, s8, v40
    v_bfi_b32 v41, v15, s9, v41
    v_bfi_b32 v42, v15, s10, v42
    v_bfi_b32 v43, v15, s94, v43
    buffer_store_dwordx4 v[40:43], v10, s[28:31], s69 offen
    s_mov_b32 exec_hi, -1
    s_barrier
    s_waitcnt vmcnt(0)
    s_endpgm
L_b:
    s_endpgm
L_final:
    buffer_load_ushort v23, v22, s[32:35], s97 offen
L_rs_poll:
    buffer_load_dwordx4 v[24:27], v21, s[28:31], s96 offen sc1
    s_waitcnt vmcnt(0)
    v_xor_b32 v28, s44, v24
    v_xor_b32 v29, s45, v25
    v_xor_b32 v30, s46, v26
    v_xor_b32 v31, s47, v27
    v_and_b32 v28, 0xffff, v28
    v_or3_b32 v28, v28, v29, v30
    v_or_b32 v28, v28, v31
    v_cmp_ne_u32 vcc, 0, v28
    s_cbranch_vccz L_rs_ok
    s_add_u32 s75, s75, 1
    s_and_b32 s74, s75, 31
    s_cbranch_scc1 L_rs_poll
    s_xor_b32 s96, s96, 0x4000
    buffer_wbl2 sc1
    s_cmp_lt_u32 s75, 4194304
    s_cbranch_scc1 L_rs_poll
    s_endpgm
L_rs_ok:
    v_and_b32 v24, 0xffff0000, v24
    v_lshlrev_b32 v23, 16, v23
    s_barrier
L_o_poll:
    buffer_load_dwordx4 v[44:47], v18, s[28:31], s98 offen sc1
    s_waitcnt vmcnt(0)
    v_xor_b32 v44, s44, v44
    v_xor_b32 v45, s45, v45
    v_xor_b32 v46, s46, v46
    v_xor_b32 v47, s47, v47
    v_or3_b32 v52, v44, v45, v46
    v_or_b32 v52, v52, v47
    v_cmp_ne_u32 vcc, 0, v52
    s_cbranch_vccz L_o_ok
    s_add_u32 s75, s75, 1
    s_cmp_lt_u32 s75, 32
    s_cbranch_scc1 L_o_poll
    s_branch L_o2
L_o_ok:
    s_barrier
    s_barrier
    buffer_load_dwordx4 v[64:67], v11, s[28:31], s72 offen sc1
    buffer_load_dwordx4 v[68:71], v11, s[28:31], s72 offen offset:512 sc1
    s_mov_b32 s52, 12
L_y2:
    buffer_load_dwordx4 v[72:75], v11, s[28:31], s72 offen sc1
    buffer_load_dwordx4 v[76:79], v11, s[28:31], s72 offen offset:512 sc1
    s_waitcnt vmcnt(2)
    v_xor_b32 v44, s8, v64
    v_xor_b32 v45, s9, v65
    v_xor_b32 v46, s10, v66
    v_xor_b32 v47, s94, v67
    v_xor_b32 v48, s8, v68
    v_xor_b32 v49, s9, v69
    v_xor_b32 v50, s10, v70
    v_xor_b32 v51, s94, v71
    v_or3_b32 v52, v44, v45, v46
    v_or3_b32 v53, v47, v48, v49
    v_or3_b32 v52, v52, v50, v51
    v_or_b32 v52, v52, v53
    v_and_b32 v52, v52, v15
    v_cmp_ne_u32 vcc, 0, v52
    s_cbranch_vccz L_y_ok
    buffer_load_dwordx4 v[64:67], v11, s[28:31], s72 offen sc1
    buffer_load_dwordx4 v[68:71], v11, s[28:31], s72 offen offset:512 sc1
    s_waitcnt vmcnt(2)
    v_xor_b32 v44, s8, v72
    v_xor_b32 v45, s9, v73
    v_xor_b32 v46, s10, v74
    v_xor_b32 v47, s94, v75
    v_xor_b32 v48, s8, v76
    v_xor_b32 v49, s9, v77
    v_xor_b32 v50, s10, v78
    v_xor_b32 v51, s94, v79
    v_or3_b32 v52, v44, v45, v46
    v_or3_b32 v53, v47, v48, v49
    v_or3_b32 v52, v52, v50, v51
    v_or_b32 v52, v52, v53
    v_and_b32 v52, v52, v15
    v_cmp_ne_u32 vcc, 0, v52
    s_cbranch_vccz L_y_ok
    s_sub_u32 s52, s52, 1
    s_cbranch_scc0 L_y2
L_y_poll:
    buffer_load_dwordx4 v[44:47], v11, s[28:31], s72 offen sc1
    buffer_load_dwordx4 v[48:51], v11, s[28:31], s72 offen offset:512 sc1
    s_waitcnt vmcnt(0)
    v_xor_b32 v44, s8, v44
    v_xor_b32 v45, s9, v45
    v_xor_b32 v46, s10, v46
    v_xor_b32 v47, s94, v47
    v_xor_b32 v48, s8, v48
    v_xor_b32 v49, s9, v49
    v_xor_b32 v50, s10, v50
    v_xor_b32 v51, s94, v51
    v_or3_b32 v52, v44, v45, v46
    v_or3_b32 v53, v47, v48, v49
    v_or3_b32 v52, v52, v50, v51
    v_or_b32 v52, v52, v53
    v_and_b32 v52, v52, v15
    v_cmp_ne_u32 vcc, 0, v52
    s_cbranch_vccz L_y_ok
    s_add_u32 s75, s75, 1
    s_cmp_lt_u32 s75, 32
    s_cbranch_scc1 L_y_poll
    s_mov_b32 s95, 1
    v_and_b32 v47, -8, v47
    v_and_b32 v51, -8, v51
    v_or3_b32 v52, v44, v45, v46
    v_or3_b32 v53, v47, v48, v49
    v_or3_b32 v52, v52, v50, v51
    v_or_b32 v52, v52, v53
    v_and_b32 v52, v52, v15
    v_cmp_ne_u32 vcc, 0, v52
    s_cbranch_vccz L_y_ok
    s_and_b32 s74, s75, 31
    s_cbranch_scc1 L_y_poll
    buffer_wbl2 sc1
    s_cmp_lt_u32 s75, 4194304
    s_cbranch_scc1 L_y_poll
    s_endpgm
L_y_ok:
    v_add_f32 v44, v44, v48
    v_add_f32 v45, v45, v49
    v_add_f32 v46, v46, v50
    v_add_f32 v47, v47, v51
    s_nop 1
    v_permlane32_swap_b32 v44, v46
    v_permlane32_swap_b32 v45, v47
    v_add_f32 v44, v44, v46
    v_add_f32 v45, v45, v47
    s_nop 1
    v_permlane16_swap_b32 v44, v45
    v_add_f32 v44, v44, v45
    s_nop 1
    v_add_f32_dpp v44, v44, v44 row_ror:8 row_mask:0xf bank_mask:0xf
    v_cvt_pk_bf16_f32 v44, v44, v44
    v_and_b32 v44, 0xffff0000, v44
    v_mul_f32 v44, v44, v24
    v_cvt_pk_bf16_f32 v44, v44, v44
    v_and_b32 v44, 0xffff0000, v44
    v_fma_f32 v44, v23, 0, v44
    v_add_f32 v44, v23, v44
    v_cvt_pk_bf16_f32 v44, v44, v44
    s_mov_b32 exec_lo, 0x00ff00ff
    s_mov_b32 exec_hi, 0x00ff00ff
    buffer_store_short v44, v22, s[36:39], s97 offen
    s_cmp_lg_u32 s2, 0
    s_cbranch_scc1 L_fin
    v_mov_b32 v28, s4
    v_mov_b32 v29, s5
    v_mov_b32 v30, s6
    v_mov_b32 v31, s7
    v_mov_b32 v32, 0
    s_mov_b64 exec, 1
    buffer_store_dwordx4 v[28:31], v32, s[28:31], 0 offen
L_fin:
    s_cmp_eq_u32 s95, 0
    s_cbranch_scc1 L_end
    s_barrier
    buffer_wbl2 sc1
    s_waitcnt vmcnt(0)
    s_endpgm
L_o2:
    s_lshl_b32 s98, s98, 4
    s_sub_u32 s98, s98, 458752
L_o2_poll:
    buffer_load_dwordx4 v[44:47], v12, s[28:31], s98 offen sc1
    buffer_load_dwordx4 v[48:51], v12, s[28:31], s98 offen offset:1024 sc1
    s_waitcnt vmcnt(0)
    v_xor_b32 v44, s44, v44
    v_xor_b32 v45, s45, v45
    v_xor_b32 v46, s46, v46
    v_xor_b32 v47, s47, v47
    v_xor_b32 v48, s44, v48
    v_xor_b32 v49, s45, v49
    v_xor_b32 v50, s46, v50
    v_xor_b32 v51, s47, v51
    v_or3_b32 v52, v44, v45, v46
    v_or3_b32 v53, v47, v48, v49
    v_or3_b32 v52, v52, v50, v51
    v_or_b32 v52, v52, v53
    v_and_b32 v52, 0xffff, v52
    v_cmp_ne_u32 vcc, 0, v52
    s_cbranch_vccz L_o_ok
    s_add_u32 s75, s75, 1
    s_and_b32 s74, s75, 31
    s_cbranch_scc1 L_o2_poll
    buffer_wbl2 sc1
    s_cmp_lt_u32 s75, 4194304
    s_cbranch_scc1 L_o2_poll
    s_endpgm
L_router:
    s_waitcnt vmcnt(11)
    s_barrier
    s_waitcnt vmcnt(3)
    v_mov_b32 v36, 0
    v_dot2_f32_bf16 v36, v64, v72, v36
    v_dot2_f32_bf16 v36, v65, v73, v36
    v_dot2_f32_bf16 v36, v66, v74, v36
    v_dot2_f32_bf16 v36, v67, v75, v36
    v_dot2_f32_bf16 v36, v68, v76, v36
    v_dot2_f32_bf16 v36, v69, v77, v36
    v_dot2_f32_bf16 v36, v70, v78, v36
    v_dot2_f32_bf16 v36, v71, v79, v36
    s_nop 2
    v_add_f32_dpp v36, v36, v36 quad_perm:[1,0,3,2] row_mask:0xf bank_mask:0xf
    s_nop 2
    v_add_f32_dpp v36, v36, v36 quad_perm:[2,3,0,1] row_mask:0xf bank_mask:0xf
    s_nop 2
    v_add_f32_dpp v36, v36, v36 row_half_mirror row_mask:0xf bank_mask:0xf
    s_nop 2
    v_add_f32_dpp v36, v36, v36 row_mirror row_mask:0xf bank_mask:0xf
    v_mov_b32 v37, v36
    s_nop 1
    v_permlane16_swap_b32 v36, v37
    v_add_f32 v36, v36, v37
    v_mov_b32 v37, v36
    s_nop 1
    v_permlane32_swap_b32 v36, v37
    v_add_f32 v36, v36, v37
    v_cvt_pk_bf16_f32 v36, v36, v36
    v_and_b32 v36, 0xffff0000, v36
    v_mul_f32 v36, 0xbfb8aa3b, v36
    v_exp_f32 v36, v36
    s_nop 0
    v_add_f32 v36, 1.0, v36
    v_rcp_f32 v36, v36
    s_and_b32 s64, s44, 0xffff
    v_cvt_pk_bf16_f32 v36, v36, v36
    v_lshl_or_b32 v36, v36, 16, s64
    v_mov_b32 v37, s45
    v_mov_b32 v38, s46
    v_mov_b32 v39, s47
    s_barrier
    s_waitcnt vmcnt(1)
    s_barrier
    s_waitcnt vmcnt(0)
    s_barrier
    s_mov_b64 exec, 0xff
    buffer_store_dwordx4 v[36:39], v12, s[28:31], s62 offen
    s_xor_b32 s62, s62, 0x4000
    s_barrier
    buffer_store_dwordx4 v[36:39], v12, s[28:31], s62 offen sc1
    s_mov_b64 exec, -1
    s_branch L_defer
L_end:
    s_endpgm
.section .rodata,"a"
.p2align 6
.amdhsa_kernel standalone__moe_arch_mod__decode_kernel
  .amdhsa_next_free_vgpr 160
  .amdhsa_next_free_sgpr 102
  .amdhsa_accum_offset 160
  .amdhsa_group_segment_fixed_size 0
  .amdhsa_kernarg_size 64
  .amdhsa_user_sgpr_count 2
  .amdhsa_user_sgpr_kernarg_segment_ptr 1
  .amdhsa_system_sgpr_workgroup_id_x 1
  .amdhsa_float_denorm_mode_32 3
.end_amdhsa_kernel
```
